```python
import torch

def _softmax(x, axis=-1):
    return torch.softmax(x, dim=axis)
def _gelu(x):
    return torch.nn.functional.gelu(x, approximate="tanh")
def _silu(x):
    return torch.nn.functional.silu(x)
def _sigmoid(x):
    return torch.sigmoid(x)
def _layernorm(x, axis=-1, eps=1e-5):
    m = x.mean(dim=axis, keepdim=True)
    v = x.var(dim=axis, keepdim=True, unbiased=False)
    return (x - m) / torch.sqrt(v + eps)
def _scatter_add(tgt, idx, src, axis=0):
    return tgt.clone().index_add_(axis, idx, src)
def _segment_sum(src, seg, n):
    out = torch.zeros((n,) + src.shape[1:], dtype=src.dtype)
    return out.index_add_(0, seg, src)
def _pad(x, pw):
    flat = tuple(v for pair in reversed(pw) for v in pair)
    return torch.nn.functional.pad(x, flat)

kernel_name = 'standalone__linear_kernel_rfa__decode'

def setup_inputs():

    _w = (lambda a: (lambda t: t.to(torch.bfloat16) if t.is_floating_point() else t)(torch.as_tensor(a)))
    B, H, Sq, Sk, D, M = 2, 32, 1, 4096, 128, 64
    return {
        "q": _w((lambda *s: torch.randn(*s, dtype=torch.bfloat16) * 0.4)(B, H, Sq, D)),
        "k": _w((lambda *s: torch.randn(*s, dtype=torch.bfloat16) * 1.6)(B, H, Sk, D)),
        "v": _w((lambda *s: torch.randn(*s, dtype=torch.bfloat16) * 1.6)(B, H, Sk, D)),
        "omega": _w((lambda *s: torch.randn(*s, dtype=torch.bfloat16) * 1.6)(M, D)),
    }

def reference(q, k, v, omega):
    d = q.shape[-1]
    m = omega.shape[0]
    scale = float(d) ** -0.25
    qs = q * scale
    ks = k * scale
    q_proj = torch.einsum("bhsd,md->bhsm", qs, omega)
    k_proj = torch.einsum("bhsd,md->bhsm", ks, omega)
    q_sq = 0.5 * torch.einsum("bhsd,bhsd->bhs", qs, qs)[..., None]
    k_sq = 0.5 * torch.einsum("bhsd,bhsd->bhs", ks, ks)[..., None]
    inv_sqrt_m = float(m) ** -0.5
    phi_q = torch.exp(q_proj - q_sq) * inv_sqrt_m + 1e-6
    phi_k = torch.exp(k_proj - k_sq) * inv_sqrt_m + 1e-6
    kv = torch.einsum("bhsm,bhsd->bhmd", phi_k, v)
    z  = torch.einsum("bhsm->bhm", phi_k)
    num = torch.einsum("bhqm,bhmd->bhqd", phi_q, kv)
    den = torch.einsum("bhqm,bhm->bhq", phi_q, z)[..., None] + 1e-6
    return num / den
```

```asm
; @launch grid=(256,1,1) block=(320,1,1) lds=157952
.amdgcn_target "amdgcn-amd-amdhsa--gfx950"
.text
.globl standalone__linear_kernel_rfa__decode_kernel
.p2align 12
.p2align 8
.type standalone__linear_kernel_rfa__decode_kernel,@function
standalone__linear_kernel_rfa__decode_kernel:
    s_load_dwordx2 s[4:5], s[0:1], 8
    s_load_dwordx2 s[12:13], s[0:1], 24
    s_load_dwordx2 s[16:17], s[0:1], 0
    s_getpc_b64 s[60:61]
L_pc:
    v_subrev_u32 v7, 64, v0
    v_lshlrev_b32 v7, 7, v7
    v_cmp_gt_u32 vcc, L_codeend-L_pc-3, v7
    v_mov_b32 v163, s61
    s_cbranch_vccz L_nopf
    s_mov_b64 exec, vcc
    v_add_co_u32 v162, vcc, s60, v7
    s_nop 1
    v_addc_co_u32 v163, vcc, 0, v163, vcc
    global_load_dword v160, v[162:163], off
    s_mov_b64 exec, -1
L_nopf:
    v_readfirstlane_b32 s26, v0
    v_bfe_u32 v22, v0, 4, 2
    v_and_b32 v23, 15, v0
    s_cmp_ge_u32 s2, 256
    s_cbranch_scc1 L_end
    v_xor_b32 v7, v22, v23
    v_lshlrev_b32 v7, 4, v7
    s_and_b32 s34, s2, 0x2d
    s_mul_i32 s34, s34, 0x811000
    s_and_b32 s34, s34, 0x2a48000
    s_and_b32 s29, s2, 0x46
    s_mul_i32 s29, s29, 0x1040000
    s_and_b32 s29, s29, 0x3100000
    s_xor_b32 s34, s34, s29
    s_lshl_b32 s29, s2, 15
    s_and_b32 s29, s29, 0x480000
    s_xor_b32 s34, s34, s29
    s_lshr_b32 s27, s34, 20
    s_cmp_lg_u32 s26, 0
    s_cbranch_scc1 L_cons
    s_setprio 3
    s_brev_b32 s6, 32
    s_mov_b32 s7, 0x20000
    s_mov_b32 m0, 0
    v_mul_u32_u24 v19, 0xa00, v22
    v_and_b32 v19, 0x1200, v19
    s_mov_b32 s38, 0x1005001
    s_mov_b32 s39, 0x12450
    v_or_b32 v176, v19, v7
    v_xor_b32 v177, 0x840, v176
    v_xor_b32 v178, 0x2080, v176
    v_xor_b32 v179, 0x28c0, v176
    v_add_u32 v177, 0xfffffc00, v177
    v_add_u32 v178, 0xfffff800, v178
    v_add_u32 v179, 0xfffff400, v179
    s_mov_b32 s40, s34
    s_waitcnt lgkmcnt(0)
L_k0:
    buffer_load_dwordx4 v176, s[4:7], s34 offen offset:0 nt lds
    buffer_load_dwordx4 v177, s[4:7], s34 offen offset:1024 nt lds
    buffer_load_dwordx4 v178, s[4:7], s34 offen offset:2048 nt lds
    buffer_load_dwordx4 v179, s[4:7], s34 offen offset:3072 nt lds
    s_and_b32 s29, s38, 0xfff
    s_addk_i32 m0, 4096
    s_lshl_b32 s29, s29, 8
    s_lshr_b64 s[38:39], s[38:39], 12
    s_xor_b32 s34, s34, s29
    s_cmpk_lt_u32 m0, 24576
    s_cbranch_scc1 L_k0
    s_branch L_setup
L_cons:
    v_lshl_add_u32 v176, v22, 8, v7
    v_xor_b32 v177, 64, v176
    v_xor_b32 v178, 0x80, v176
    v_xor_b32 v179, 64, v178
    v_and_b32 v21, 63, v0
    s_lshl_b32 s29, s27, 8
    v_lshl_add_u32 v64, v21, 2, s29
    s_lshl_b32 s30, s26, 6
    s_add_u32 m0, s30, 126976
    s_addk_i32 s30, -4096
    s_movk_i32 s14, 16384
    s_mov_b32 s15, 0x20000
    s_waitcnt lgkmcnt(0)
    buffer_load_dwordx4 v176, s[12:15], s30 offen offset:0 lds
    buffer_load_dwordx4 v177, s[12:15], s30 offen offset:1024 lds
    buffer_load_dwordx4 v178, s[12:15], s30 offen offset:2048 lds
    buffer_load_dwordx4 v179, s[12:15], s30 offen offset:3072 lds
    global_load_dword v64, v64, s[16:17]
    s_load_dwordx2 s[24:25], s[0:1], 48
    s_load_dwordx2 s[20:21], s[0:1], 32
    s_lshr_b32 s33, s30, 12
    s_bfe_u32 s28, s2, 0x20003
    s_mov_b32 s32, 0x100000
    v_lshlrev_b32 v1, 2, v21
    v_add_u32 v1, 147712, v1
    s_lshl_b32 s30, s33, 8
    v_add_u32 v2, s30, v1
    v_mov_b32 v152, 0
    ds_write_b32 v2, v152 offset:256
    s_lshl_b32 s30, s33, 13
    v_lshl_add_u32 v7, v23, 8, v7
    v_add_u32 v8, s30, v7
    v_xor_b32 v9, 64, v8
    v_xor_b32 v10, 0x80, v8
    v_xor_b32 v11, 0xc0, v8
    v_add_u32 v148, 131072, v7
    v_xor_b32 v149, 64, v148
    v_xor_b32 v150, 0x80, v148
    v_xor_b32 v151, 0xc0, v148
    v_lshrrev_b32 v7, 2, v21
    v_and_b32 v12, 7, v7
    v_lshlrev_b32 v12, 5, v12
    v_lshl_add_u32 v12, v7, 8, v12
    v_and_b32 v7, 3, v21
    v_lshl_add_u32 v12, v7, 3, v12
    s_add_u32 s30, s29, 524288
    v_mov_b32 v161, s30
    s_add_u32 s31, s30, 128
    s_waitcnt lgkmcnt(0)
    s_load_dword s42, s[24:25], s31
    s_load_dwordx2 s[62:63], s[24:25], s30
    v_lshlrev_b32 v131, 4, v22
    s_lshl_b32 s30, s33, 8
    v_lshl_add_u32 v5, v23, 4, s30
    v_add_u32 v7, 1, v22
    v_xor_b32 v7, s28, v7
    s_lshl2_add_u32 s30, s33, -4
    s_lshl4_add_u32 s29, s30, s29
    v_lshl_add_u32 v22, v21, 1, s29
    s_lshl_b32 s29, s27, 13
    v_lshl_add_u32 v186, v7, 11, s29
    v_add_u32 v186, v186, v5
    v_or_b32 v186, 0x400, v186
    s_lshl_b32 s29, s33, 6
    v_xor_b32 v12, s29, v12
    v_xor_b32 v13, 32, v12
    v_add_u32 v15, 155648, v131
    v_add_u32 v14, s29, v15
    s_lshl_b32 s29, s33, 10
    s_add_u32 s29, s29, 151552
    v_add_u32 v131, s29, v131
    v_lshl_add_u32 v130, v21, 2, s29
    s_lshl2_add_u32 s29, s27, s28
    s_lshl_b32 s29, s29, 11
    v_add_u32 v6, s29, v5
    s_mov_b32 s36, 0xffff0000
    s_mov_b32 s38, 0x3e9837f0
    s_mov_b32 s40, 0x3fb8aa3b
    v_mov_b32 v20, -0.5
    s_mov_b32 s44, 0x00010001
    s_mov_b32 s45, s44
    s_mov_b32 s34, 0x8000
    s_mov_b32 s48, 0x00100001
    s_mov_b32 s49, 0x10000100
    s_lshl_b64 s[50:51], s[48:49], 1
    s_lshl_b64 s[52:53], s[48:49], 2
    s_lshl_b64 s[54:55], s[48:49], 3
    v_mov_b32 v24, 0x3f803f80
    v_mov_b32 v25, v24
    v_mov_b32 v26, v24
    v_mov_b32 v27, v24
    v_mov_b32 v153, 0
    v_mov_b32 v154, 0
    v_mov_b32 v155, 0
    v_mov_b32 v156, 0
    v_mov_b32 v157, 0
    v_mov_b32 v158, 0
    v_mov_b32 v159, 0
    v_mov_b32 v168, 0
    v_mov_b32 v169, 0
    v_mov_b32 v170, 0
    v_mov_b32 v171, 0
    s_movk_i32 s57, 9216
    s_movk_i32 s58, 11264
    s_lshl_b32 s35, s26, 2
    s_waitcnt vmcnt(0)
    v_lshlrev_b32 v144, 16, v64
    v_and_b32 v145, s36, v64
    v_mul_f32 v144, s38, v144
    v_mul_f32 v145, s38, v145
    v_cvt_pk_bf16_f32 v144, v144, v145
    s_barrier
    ds_write_b32 v130, v144
    s_waitcnt lgkmcnt(0)
    ds_read_b128 v[64:67], v131 offset:0
    ds_read_b128 v[68:71], v131 offset:64
    ds_read_b128 v[72:75], v131 offset:128
    ds_read_b128 v[76:79], v131 offset:192
    ds_read_b128 v[192:195], v148 offset:0
    ds_read_b128 v[208:211], v148 offset:4096
    ds_read_b128 v[224:227], v148 offset:8192
    ds_read_b128 v[240:243], v148 offset:12288
    ds_read_b128 v[196:199], v149 offset:0
    ds_read_b128 v[212:215], v149 offset:4096
    ds_read_b128 v[228:231], v149 offset:8192
    ds_read_b128 v[244:247], v149 offset:12288
    ds_read_b128 v[200:203], v150 offset:0
    ds_read_b128 v[216:219], v150 offset:4096
    ds_read_b128 v[232:235], v150 offset:8192
    ds_read_b128 v[248:251], v150 offset:12288
    ds_read_b128 v[204:207], v151 offset:0
    ds_read_b128 v[220:223], v151 offset:4096
    ds_read_b128 v[236:239], v151 offset:8192
    ds_read_b128 v[252:255], v151 offset:12288
    s_waitcnt lgkmcnt(12)
    v_mfma_f32_16x16x32_bf16 v[52:55], v[64:67], v[64:67], 0
    v_mfma_f32_16x16x32_bf16 v[96:99], v[192:195], v[64:67], 0
    v_mfma_f32_16x16x32_bf16 v[100:103], v[208:211], v[64:67], 0
    v_mfma_f32_16x16x32_bf16 v[104:107], v[224:227], v[64:67], 0
    v_mfma_f32_16x16x32_bf16 v[108:111], v[240:243], v[64:67], 0
    s_waitcnt lgkmcnt(8)
    v_mfma_f32_16x16x32_bf16 v[52:55], v[68:71], v[68:71], v[52:55]
    v_mfma_f32_16x16x32_bf16 v[96:99], v[196:199], v[68:71], v[96:99]
    v_mfma_f32_16x16x32_bf16 v[100:103], v[212:215], v[68:71], v[100:103]
    v_mfma_f32_16x16x32_bf16 v[104:107], v[228:231], v[68:71], v[104:107]
    v_mfma_f32_16x16x32_bf16 v[108:111], v[244:247], v[68:71], v[108:111]
    s_waitcnt lgkmcnt(4)
    v_mfma_f32_16x16x32_bf16 v[52:55], v[72:75], v[72:75], v[52:55]
    v_mfma_f32_16x16x32_bf16 v[96:99], v[200:203], v[72:75], v[96:99]
    v_mfma_f32_16x16x32_bf16 v[100:103], v[216:219], v[72:75], v[100:103]
    v_mfma_f32_16x16x32_bf16 v[104:107], v[232:235], v[72:75], v[104:107]
    v_mfma_f32_16x16x32_bf16 v[108:111], v[248:251], v[72:75], v[108:111]
    s_waitcnt lgkmcnt(0)
    v_mfma_f32_16x16x32_bf16 v[52:55], v[76:79], v[76:79], v[52:55]
    v_mfma_f32_16x16x32_bf16 v[96:99], v[204:207], v[76:79], v[96:99]
    v_mfma_f32_16x16x32_bf16 v[100:103], v[220:223], v[76:79], v[100:103]
    v_mfma_f32_16x16x32_bf16 v[104:107], v[236:239], v[76:79], v[104:107]
    v_mfma_f32_16x16x32_bf16 v[108:111], v[252:255], v[76:79], v[108:111]
    s_nop 3
    v_mul_f32 v52, -0.5, v52
    s_nop 2
    s_branch L_phi0
L_setup:
    s_load_dwordx2 s[8:9], s[0:1], 16
    s_load_dwordx2 s[24:25], s[0:1], 48
    s_load_dwordx2 s[44:45], s[0:1], 40
    s_mov_b32 s32, 0x100000
    s_movk_i32 s33, 256
    s_movk_i32 s36, 24576
    v_lshlrev_b32 v7, 1, v22
    v_xor_b32 v7, v7, v23
    v_lshlrev_b32 v7, 4, v7
    v_mov_b32 v20, s40
    v_bfe_i32 v10, v0, 0, 1
    v_and_b32 v10, 0x400, v10
    v_xor_b32 v20, v20, v10
    v_bfe_i32 v10, v0, 1, 1
    v_and_b32 v10, 0x24000, v10
    v_xor_b32 v20, v20, v10
    v_bfe_i32 v10, v0, 2, 1
    v_and_b32 v10, 0x10000, v10
    v_xor_b32 v20, v20, v10
    v_bfe_i32 v10, v0, 3, 1
    v_and_b32 v10, 0x40000, v10
    v_xor_b32 v20, v20, v10
    v_bfe_i32 v10, v0, 4, 1
    v_and_b32 v10, 0x20000, v10
    v_xor_b32 v20, v20, v10
    v_or_b32 v5, v19, v7
    v_xor_b32 v6, 0x880, v5
    v_xor_b32 v17, 0x2000, v5
    v_xor_b32 v18, 0x2880, v5
    v_add_u32 v6, 0xfffffc00, v6
    v_add_u32 v17, 0xfffff800, v17
    v_add_u32 v18, 0xfffff400, v18
    v_readlane_b32 s34, v20, 3
    s_mov_b32 s37, 3
    v_lshlrev_b32 v8, 2, v0
    v_add_u32 v8, 147712, v8
    v_and_b32 v7, 3, v0
    v_lshl_add_u32 v9, v7, 8, v8
    s_lshl_b32 s29, s27, 8
    s_add_u32 s29, s29, 524288
    v_mov_b32 v12, s29
    s_getreg_b32 s41, hwreg(HW_REG_XCC_ID, 0, 3)
    s_lshl1_add_u32 s41, s41, 16
    s_mov_b32 s49, 64
    s_bitset1_b32 s49, s41
    v_mov_b32 v16, s49
    s_movk_i32 s49, 0xc0
    s_add_u32 s50, s29, 128
    v_mov_b32 v15, 0
    s_lshr_b32 s56, s2, 3
    s_mov_b32 s46, 0
    s_mov_b32 s47, 0x20000
    v_mov_b32 v24, 0
    v_lshlrev_b32 v25, 2, v0
    v_lshl_add_u32 v26, v0, 5, s56
    v_lshlrev_b32 v26, 2, v26
    s_waitcnt lgkmcnt(0)
    s_load_dword s60, s[44:45], 0
    buffer_load_dword v27, v25, s[44:47], 0 offen offset:128
    buffer_load_dword v27, v25, s[44:47], 0 offen offset:128
    buffer_load_dword v27, v25, s[44:47], 0 offen offset:128
    buffer_load_dword v27, v25, s[44:47], 0 offen offset:128
    buffer_load_dword v27, v25, s[44:47], 0 offen offset:128
L_k:
    s_mov_b32 m0, s36
    s_xor_b32 s29, s34, 0x100
    s_add_u32 s37, s37, 1
    s_sub_u32 s62, s33, 768
    s_cmpk_ge_u32 s62, 14592
    s_cselect_b32 s62, 0, 12
    v_readlane_b32 s57, v24, s56
    s_sub_u32 s55, s33, 512
    s_add_u32 s54, s57, 512
    s_addk_i32 s57, 256
    v_cmp_le_u32_e64 s[58:59], s54, v24
    v_cmp_le_u32 vcc, s57, v24
    s_bcnt1_i32_b32 s54, s58
    s_bcnt1_i32_b32 s57, vcc_lo
    s_cmp_ge_u32 s54, 12
    s_waitcnt vmcnt(41)
    s_cbranch_scc1 L_deep
    s_addk_i32 s55, 256
    s_cmp_ge_u32 s57, s62
    s_waitcnt vmcnt(31)
    s_cbranch_scc1 L_deep
    s_addk_i32 s55, 256
    s_waitcnt vmcnt(21)
L_deep:
    buffer_load_dwordx4 v176, s[4:7], s34 offen offset:0 nt lds
    buffer_load_dwordx4 v177, s[4:7], s34 offen offset:1024 nt lds
    buffer_load_dwordx4 v178, s[4:7], s34 offen offset:2048 nt lds
    buffer_load_dwordx4 v179, s[4:7], s34 offen offset:3072 nt lds
    s_addk_i32 m0, 4096
    s_addk_i32 s36, 8192
    buffer_load_dwordx4 v176, s[4:7], s29 offen offset:0 nt lds
    buffer_load_dwordx4 v177, s[4:7], s29 offen offset:1024 nt lds
    buffer_load_dwordx4 v178, s[4:7], s29 offen offset:2048 nt lds
    buffer_load_dwordx4 v179, s[4:7], s29 offen offset:3072 nt lds
    v_mov_b32 v28, s55
    buffer_store_dword v28, v26, s[44:47], 0 offen
    buffer_load_dword v24, v25, s[44:47], 0 offen sc0
    v_bfe_u32 v10, v15, s41, 2
    v_readlane_b32 s34, v20, s37
    v_or_b32 v10, s55, v10
    s_bitset0_b32 s36, 17
    v_and_or_b32 v10, v15, s49, v10
    s_addk_i32 s33, 256
    s_sub_u32 s30, s33, 3328
    ds_write_b32 v8, v10
    s_cbranch_scc0 L_poll0
    s_cmpk_lg_u32 s33, 1024
    s_cbranch_scc1 L_k
    s_waitcnt lgkmcnt(0)
    s_movk_i32 s46, 128
    s_barrier
    s_branch L_k
L_poll0:
    ds_read_b32 v11, v9 offset:256
    s_sub_u32 s32, s32, 1
    s_cbranch_scc1 L_end
    s_bitcmp1_b32 s37, 5
    s_waitcnt lgkmcnt(0)
    v_cmp_gt_u32 vcc, s30, v11
    s_cbranch_vccnz L_poll0
    s_cbranch_scc1 L_flip
    s_cmpk_lg_u32 s33, 15104
    s_cbranch_scc1 L_k
    s_mov_b64 exec, 1
    s_waitcnt vmcnt(31)
    global_atomic_add v15, v12, v16, s[24:25] sc0 sc1
    s_mov_b64 exec, -1
    s_branch L_k
L_flip:
    s_mov_b32 s37, 0
    s_mov_b64 s[4:5], s[8:9]
    v_mov_b32 v176, v5
    v_mov_b32 v177, v6
    v_mov_b32 v178, v17
    v_mov_b32 v179, v18
    s_bitcmp1_b32 s33, 13
    s_cbranch_scc0 L_k
    v_mov_b32 v10, 15360
    s_waitcnt vmcnt(42)
    ds_write_b32 v8, v10
    s_waitcnt vmcnt(30)
    v_bfe_u32 v10, v15, s41, 2
    v_or_b32 v10, 15616, v10
    v_and_or_b32 v10, v15, s49, v10
    ds_write_b32 v8, v10
    s_waitcnt lgkmcnt(0)
    v_readfirstlane_b32 s31, v15
    s_mov_b32 s51, 0x9e3779b9
    s_and_b32 s31, s31, s49
    s_cmp_eq_u32 s31, s49
    s_barrier
    s_cbranch_scc0 L_lnw
    s_atomic_add s51, s[24:25], s50
L_lnw:
    s_waitcnt vmcnt(22)
    s_barrier
    s_waitcnt vmcnt(12)
    s_barrier
    s_waitcnt vmcnt(2)
    s_barrier
    s_endpgm
L_rp:
    ds_read_b32 v4, v1
    s_sub_u32 s32, s32, 1
    s_cbranch_scc0 L_pk
    s_endpgm
L_loop:
    v_lshlrev_b32 v144, 16, v64
    v_and_b32 v145, s36, v64
    v_mul_f32 v144, s38, v144
    v_mul_f32_e64 v145, s38, v145
    v_cvt_pk_bf16_f32 v64, v144, v145
    v_lshlrev_b32 v146, 16, v65
    v_and_b32 v147, s36, v65
    v_mul_f32 v146, s38, v146
    v_mul_f32 v147, s38, v147
    v_cvt_pk_bf16_f32 v65, v146, v147
    v_lshlrev_b32 v144, 16, v66
    v_and_b32 v145, s36, v66
    v_mul_f32 v144, s38, v144
    v_mul_f32 v145, s38, v145
    v_cvt_pk_bf16_f32 v66, v144, v145
    v_lshlrev_b32 v146, 16, v67
    v_and_b32 v147, s36, v67
    v_mul_f32 v146, s38, v146
    v_mul_f32 v147, s38, v147
    v_cvt_pk_bf16_f32 v67, v146, v147
    v_cvt_pk_bf16_f32 v40, v44, v45
    v_cvt_pk_bf16_f32 v41, v46, v47
    v_cvt_pk_bf16_f32 v42, v48, v49
    v_cvt_pk_bf16_f32 v43, v50, v51
    v_lshlrev_b32 v144, 16, v68
    s_mov_b64 exec, s[44:45]
    ds_write_b128 v14, v[40:43]
    s_mov_b64 exec, -1
    v_and_b32 v145, s36, v68
    v_add_u32 v14, 256, v14
    v_mfma_f32_16x16x32_bf16 v[52:55], v[64:67], v[64:67], 0
    v_mul_f32 v144, s38, v144
    v_mul_f32 v145, s38, v145
    v_cvt_pk_bf16_f32 v68, v144, v145
    v_lshlrev_b32_e64 v146, 16, v69
    v_mfma_f32_16x16x32_bf16 v[96:99], v[192:195], v[64:67], 0
    v_and_b32 v147, s36, v69
    v_mul_f32 v146, s38, v146
    v_mul_f32_e64 v147, s38, v147
    v_cvt_pk_bf16_f32 v69, v146, v147
    v_mfma_f32_16x16x32_bf16 v[100:103], v[208:211], v[64:67], 0
    v_lshlrev_b32 v144, 16, v70
    v_and_b32 v145, s36, v70
    v_mul_f32 v144, s38, v144
    v_mul_f32 v145, s38, v145
    v_mfma_f32_16x16x32_bf16 v[104:107], v[224:227], v[64:67], 0
    v_cvt_pk_bf16_f32 v70, v144, v145
    v_lshlrev_b32 v146, 16, v71
    v_and_b32 v147, s36, v71
    v_mul_f32_e64 v146, s38, v146
    v_mfma_f32_16x16x32_bf16 v[108:111], v[240:243], v[64:67], 0
    v_mul_f32_e64 v147, s38, v147
    v_cvt_pk_bf16_f32 v71, v146, v147
    v_lshlrev_b32 v144, 16, v72
    v_and_b32 v145, s36, v72
    v_mfma_f32_16x16x32_bf16 v[52:55], v[68:71], v[68:71], v[52:55]
    v_mul_f32 v144, s38, v144
    v_mul_f32 v145, s38, v145
    v_cvt_pk_bf16_f32 v72, v144, v145
    v_lshlrev_b32_e64 v146, 16, v73
    v_mfma_f32_16x16x32_bf16 v[96:99], v[196:199], v[68:71], v[96:99]
    v_and_b32 v147, s36, v73
    v_mul_f32 v146, s38, v146
    v_mul_f32_e64 v147, s38, v147
    v_cvt_pk_bf16_f32 v73, v146, v147
    v_mfma_f32_16x16x32_bf16 v[100:103], v[212:215], v[68:71], v[100:103]
    v_lshlrev_b32 v144, 16, v74
    v_and_b32 v145, s36, v74
    v_mul_f32 v144, s38, v144
    v_mul_f32 v145, s38, v145
    v_mfma_f32_16x16x32_bf16 v[104:107], v[228:231], v[68:71], v[104:107]
    v_cvt_pk_bf16_f32 v74, v144, v145
    v_lshlrev_b32 v146, 16, v75
    v_and_b32 v147, s36, v75
    v_mul_f32_e64 v146, s38, v146
    v_mfma_f32_16x16x32_bf16 v[108:111], v[244:247], v[68:71], v[108:111]
    v_mul_f32_e64 v147, s38, v147
    v_cvt_pk_bf16_f32 v75, v146, v147
    v_lshlrev_b32 v144, 16, v76
    v_and_b32 v145, s36, v76
    v_mfma_f32_16x16x32_bf16 v[52:55], v[72:75], v[72:75], v[52:55]
    v_mul_f32 v144, s38, v144
    v_mul_f32 v145, s38, v145
    v_cvt_pk_bf16_f32 v76, v144, v145
    v_lshlrev_b32_e64 v146, 16, v77
    v_mfma_f32_16x16x32_bf16 v[96:99], v[200:203], v[72:75], v[96:99]
    v_and_b32 v147, s36, v77
    v_mul_f32 v146, s38, v146
    v_mul_f32_e64 v147, s38, v147
    v_cvt_pk_bf16_f32 v77, v146, v147
    v_mfma_f32_16x16x32_bf16 v[100:103], v[216:219], v[72:75], v[100:103]
    v_lshlrev_b32 v144, 16, v78
    v_and_b32 v145, s36, v78
    v_mul_f32 v144, s38, v144
    v_mul_f32 v145, s38, v145
    v_mfma_f32_16x16x32_bf16 v[104:107], v[232:235], v[72:75], v[104:107]
    v_cvt_pk_bf16_f32 v78, v144, v145
    v_lshlrev_b32 v146, 16, v79
    v_and_b32 v147, s36, v79
    v_mul_f32_e64 v146, s38, v146
    v_mfma_f32_16x16x32_bf16 v[108:111], v[248:251], v[72:75], v[108:111]
    v_mul_f32_e64 v147, s38, v147
    v_cvt_pk_bf16_f32 v79, v146, v147
    v_lshlrev_b32 v144, 16, v80
    v_and_b32 v145, s36, v80
    v_mfma_f32_16x16x32_bf16 v[52:55], v[76:79], v[76:79], v[52:55]
    v_mul_f32 v144, s38, v144
    v_mul_f32 v145, s38, v145
    v_cvt_pk_bf16_f32 v80, v144, v145
    v_lshlrev_b32_e64 v146, 16, v81
    v_mfma_f32_16x16x32_bf16 v[96:99], v[204:207], v[76:79], v[96:99]
    v_and_b32 v147, s36, v81
    v_mul_f32 v146, s38, v146
    v_mul_f32_e64 v147, s38, v147
    v_cvt_pk_bf16_f32 v81, v146, v147
    v_mfma_f32_16x16x32_bf16 v[100:103], v[220:223], v[76:79], v[100:103]
    v_lshlrev_b32 v144, 16, v82
    v_and_b32 v145, s36, v82
    v_mul_f32 v144, s38, v144
    v_mul_f32 v145, s38, v145
    v_mfma_f32_16x16x32_bf16 v[104:107], v[236:239], v[76:79], v[104:107]
    v_cvt_pk_bf16_f32 v82, v144, v145
    v_lshlrev_b32 v146, 16, v83
    v_and_b32 v147, s36, v83
    v_mul_f32_e64 v146, s38, v146
    v_mfma_f32_16x16x32_bf16 v[108:111], v[252:255], v[76:79], v[108:111]
    v_mul_f32_e64 v147, s38, v147
    v_cvt_pk_bf16_f32 v83, v146, v147
    v_cndmask_b32_e64 v60, 0, v52, s[48:49]
    v_cndmask_b32_e64 v60, v60, v53, s[50:51]
    v_cndmask_b32_e64 v60, v60, v54, s[52:53]
    v_cndmask_b32_e64 v60, v60, v55, s[54:55]
    v_lshlrev_b32 v144, 16, v84
    v_and_b32 v145, s36, v84
    v_mfma_f32_16x16x32_bf16 v[56:59], v[80:83], v[80:83], 0
    v_mul_f32 v144, s38, v144
    v_mul_f32 v145, s38, v145
    v_cvt_pk_bf16_f32 v84, v144, v145
    v_mfma_f32_16x16x32_bf16 v[112:115], v[192:195], v[80:83], 0
    v_lshlrev_b32 v146, 16, v85
    v_and_b32 v147, s36, v85
    v_mul_f32_e64 v146, s38, v146
    v_mfma_f32_16x16x32_bf16 v[116:119], v[208:211], v[80:83], 0
    v_mul_f32_e64 v147, s38, v147
    v_cvt_pk_bf16_f32 v85, v146, v147
    v_lshlrev_b32_e64 v144, 16, v86
    v_mfma_f32_16x16x32_bf16 v[120:123], v[224:227], v[80:83], 0
    v_and_b32 v145, s36, v86
    v_mul_f32 v144, s38, v144
    v_mul_f32_e64 v145, s38, v145
    v_mfma_f32_16x16x32_bf16 v[124:127], v[240:243], v[80:83], 0
    v_cvt_pk_bf16_f32 v86, v144, v145
    v_lshlrev_b32 v146, 16, v87
    v_and_b32 v147, s36, v87
    v_mfma_f32_16x16x4_f32 v[52:55], v20, v60, 0
    v_mul_f32 v146, s38, v146
    v_mul_f32 v147, s38, v147
    v_cvt_pk_bf16_f32 v87, v146, v147
    v_lshlrev_b32 v144, 16, v88
    v_and_b32 v145, s36, v88
    v_mfma_f32_16x16x32_bf16 v[56:59], v[84:87], v[84:87], v[56:59]
    v_mul_f32 v144, s38, v144
    v_mul_f32 v145, s38, v145
    v_cvt_pk_bf16_f32 v88, v144, v145
    v_lshlrev_b32_e64 v146, 16, v89
    v_mfma_f32_16x16x32_bf16 v[112:115], v[196:199], v[84:87], v[112:115]
    v_and_b32 v147, s36, v89
    v_mul_f32 v146, s38, v146
    v_mul_f32_e64 v147, s38, v147
    v_cvt_pk_bf16_f32 v89, v146, v147
    v_mfma_f32_16x16x32_bf16 v[116:119], v[212:215], v[84:87], v[116:119]
    v_lshlrev_b32 v144, 16, v90
    v_and_b32 v145, s36, v90
    v_mul_f32 v144, s38, v144
    v_mul_f32 v145, s38, v145
    v_mfma_f32_16x16x32_bf16 v[120:123], v[228:231], v[84:87], v[120:123]
    v_cvt_pk_bf16_f32 v90, v144, v145
    v_lshlrev_b32 v146, 16, v91
    v_and_b32 v147, s36, v91
    v_mul_f32_e64 v146, s38, v146
    v_mfma_f32_16x16x32_bf16 v[124:127], v[244:247], v[84:87], v[124:127]
    v_mul_f32_e64 v147, s38, v147
    v_cvt_pk_bf16_f32 v91, v146, v147
    v_lshlrev_b32 v144, 16, v92
    v_and_b32 v145, s36, v92
    v_mfma_f32_16x16x32_bf16 v[56:59], v[88:91], v[88:91], v[56:59]
    v_mul_f32 v144, s38, v144
    v_mul_f32 v145, s38, v145
    v_cvt_pk_bf16_f32 v92, v144, v145
    v_lshlrev_b32_e64 v146, 16, v93
    v_mfma_f32_16x16x32_bf16 v[112:115], v[200:203], v[88:91], v[112:115]
    v_and_b32 v147, s36, v93
    v_mul_f32 v146, s38, v146
    v_mul_f32_e64 v147, s38, v147
    v_cvt_pk_bf16_f32 v93, v146, v147
    v_mfma_f32_16x16x32_bf16 v[116:119], v[216:219], v[88:91], v[116:119]
    v_lshlrev_b32 v144, 16, v94
    v_and_b32 v145, s36, v94
    v_mul_f32 v144, s38, v144
    v_mul_f32 v145, s38, v145
    v_mfma_f32_16x16x32_bf16 v[120:123], v[232:235], v[88:91], v[120:123]
    v_cvt_pk_bf16_f32 v94, v144, v145
    v_lshlrev_b32 v146, 16, v95
    v_and_b32 v147, s36, v95
    v_mul_f32_e64 v146, s38, v146
    v_mfma_f32_16x16x32_bf16 v[124:127], v[248:251], v[88:91], v[124:127]
    v_mul_f32_e64 v147, s38, v147
    v_cvt_pk_bf16_f32 v95, v146, v147
L_phi0:
    ds_read_b32 v4, v1
    v_cvt_pk_bf16_f32 v52, 0, v52
    v_cvt_pk_bf16_f32 v96, 0, v96
    v_mfma_f32_16x16x32_bf16 v[56:59], v[92:95], v[92:95], v[56:59]
    v_cvt_pk_bf16_f32 v97, 0, v97
    v_cvt_pk_bf16_f32 v98, 0, v98
    v_cvt_pk_bf16_f32 v99, 0, v99
    s_cmpk_gt_u32 s35, 8192
    v_add_f32 v96, v52, v96
    v_mfma_f32_16x16x32_bf16 v[112:115], v[204:207], v[92:95], v[112:115]
    v_add_f32 v97, v52, v97
    v_add_f32 v98, v52, v98
    v_add_f32_e64 v99, v52, v99
    v_cvt_pk_bf16_f32 v96, 0, v96
    v_mfma_f32_16x16x32_bf16 v[116:119], v[220:223], v[92:95], v[116:119]
    v_cvt_pk_bf16_f32 v97, 0, v97
    v_cvt_pk_bf16_f32 v98, 0, v98
    v_cvt_pk_bf16_f32 v99, 0, v99
    v_mul_f32_e64 v96, s40, v96
    v_mfma_f32_16x16x32_bf16 v[120:123], v[236:239], v[92:95], v[120:123]
    v_cndmask_b32_e64 v62, 0, v56, s[48:49]
    v_cndmask_b32_e64 v62, v62, v57, s[50:51]
    v_cndmask_b32_e64 v62, v62, v58, s[52:53]
    v_cndmask_b32_e64 v62, v62, v59, s[54:55]
    v_mfma_f32_16x16x32_bf16 v[124:127], v[252:255], v[92:95], v[124:127]
    v_mul_f32 v97, s40, v97
    v_mul_f32 v98, s40, v98
    v_mul_f32_e64 v99, s40, v99
    s_cbranch_scc1 L_nf
L_pk:
    s_waitcnt lgkmcnt(0)
    v_cmp_gt_u32 vcc, s35, v4
    s_cbranch_vccnz L_rp
    ds_read_b128 v[64:67], v8 offset:0
    ds_read_b128 v[68:71], v9 offset:0
    ds_read_b128 v[72:75], v10 offset:0
    ds_read_b128 v[76:79], v11 offset:0
    ds_read_b128 v[80:83], v8 offset:4096
    ds_read_b128 v[84:87], v9 offset:4096
    ds_read_b128 v[88:91], v10 offset:4096
    ds_read_b128 v[92:95], v11 offset:4096
    v_xor_b32 v8, s34, v8
    v_xor_b32 v9, s34, v9
    v_xor_b32 v10, s34, v10
    v_xor_b32 v11, s34, v11
    s_xor_b32 s34, s34, 0x10000
    s_add_u32 s56, s35, 768
    s_min_u32 s56, s56, 8192
L_nf:
    s_addk_i32 s35, 1024
    v_exp_f32 v96, v96
    v_mfma_f32_16x16x4_f32 v[56:59], v20, v62, 0
    v_exp_f32 v97, v97
    v_exp_f32 v98, v98
    v_exp_f32_e64 v99, v99
    v_cvt_pk_bf16_f32 v128, v96, v97
    v_cvt_pk_bf16_f32 v129, v98, v99
    v_cvt_pk_bf16_f32 v100, 0, v100
    v_cvt_pk_bf16_f32 v101, 0, v101
    v_cvt_pk_bf16_f32 v102, 0, v102
    v_cvt_pk_bf16_f32 v103, 0, v103
    v_add_f32 v100, v52, v100
    v_add_f32 v101, v52, v101
    v_add_f32 v102, v52, v102
    v_add_f32 v103, v52, v103
    v_cvt_pk_bf16_f32 v100, 0, v100
    v_cvt_pk_bf16_f32 v101, 0, v101
    v_cvt_pk_bf16_f32 v102, 0, v102
    v_cvt_pk_bf16_f32 v103, 0, v103
    v_mul_f32 v100, s40, v100
    v_mul_f32 v101, s40, v101
    v_mul_f32 v102, s40, v102
    v_mul_f32 v103, s40, v103
    v_exp_f32 v100, v100
    v_exp_f32 v101, v101
    v_exp_f32 v102, v102
    v_exp_f32 v103, v103
    v_cvt_pk_bf16_f32 v130, v100, v101
    v_cvt_pk_bf16_f32 v131, v102, v103
    v_cvt_pk_bf16_f32 v104, 0, v104
    v_cvt_pk_bf16_f32 v105, 0, v105
    v_cvt_pk_bf16_f32 v106, 0, v106
    v_cvt_pk_bf16_f32 v107, 0, v107
    v_add_f32 v104, v52, v104
    v_add_f32 v105, v52, v105
    v_add_f32 v106, v52, v106
    v_add_f32 v107, v52, v107
    v_cvt_pk_bf16_f32 v104, 0, v104
    v_cvt_pk_bf16_f32 v105, 0, v105
    v_cvt_pk_bf16_f32 v106, 0, v106
    v_cvt_pk_bf16_f32 v107, 0, v107
    v_mul_f32 v104, s40, v104
    v_mul_f32 v105, s40, v105
    v_mul_f32 v106, s40, v106
    v_mul_f32 v107, s40, v107
    v_exp_f32 v104, v104
    v_exp_f32 v105, v105
    v_exp_f32 v106, v106
    v_exp_f32 v107, v107
    v_cvt_pk_bf16_f32 v132, v104, v105
    v_cvt_pk_bf16_f32 v133, v106, v107
    v_cvt_pk_bf16_f32 v108, 0, v108
    v_cvt_pk_bf16_f32 v109, 0, v109
    v_cvt_pk_bf16_f32 v110, 0, v110
    v_cvt_pk_bf16_f32 v111, 0, v111
    v_add_f32 v108, v52, v108
    v_add_f32 v109, v52, v109
    v_add_f32 v110, v52, v110
    v_add_f32 v111, v52, v111
    v_cvt_pk_bf16_f32 v108, 0, v108
    v_cvt_pk_bf16_f32 v109, 0, v109
    v_cvt_pk_bf16_f32 v110, 0, v110
    v_cvt_pk_bf16_f32 v111, 0, v111
    v_mul_f32 v108, s40, v108
    v_mul_f32 v109, s40, v109
    v_mul_f32 v110, s40, v110
    v_mul_f32 v111, s40, v111
    v_exp_f32 v108, v108
    v_exp_f32 v109, v109
    v_exp_f32 v110, v110
    v_exp_f32 v111, v111
    v_cvt_pk_bf16_f32 v134, v108, v109
    v_cvt_pk_bf16_f32 v135, v110, v111
    s_cmpk_le_u32 s35, 2048
    s_waitcnt vmcnt(0) lgkmcnt(0)
    v_mov_b32_e64 v4, s56
    ds_write_b32 v2, v4 offset:256
    s_nop 0
    s_cbranch_scc1 L_qpost
    v_cvt_pk_bf16_f32 v56, 0, v56
    v_cvt_pk_bf16_f32 v112, 0, v112
    v_cvt_pk_bf16_f32 v113, 0, v113
    v_mfma_f32_16x16x32_bf16 v[44:47], v[128:131], v[32:35], v[28:31]
    v_cvt_pk_bf16_f32 v114, 0, v114
    v_cvt_pk_bf16_f32 v115, 0, v115
    v_add_f32 v112, v56, v112
    v_add_f32 v113, v56, v113
    v_add_f32 v114, v56, v114
    v_add_f32 v115, v56, v115
    v_mfma_f32_16x16x32_bf16 v[44:47], v[132:135], v[36:39], v[44:47]
    v_cvt_pk_bf16_f32 v112, 0, v112
    v_cvt_pk_bf16_f32 v113, 0, v113
    v_cvt_pk_bf16_f32 v114, 0, v114
    v_cvt_pk_bf16_f32 v115, 0, v115
    v_mul_f32 v112, s40, v112
    v_mul_f32 v113, s40, v113
    v_mul_f32 v114, s40, v114
    v_mul_f32 v115, s40, v115
    v_exp_f32 v112, v112
    v_exp_f32 v113, v113
    v_exp_f32 v114, v114
    v_exp_f32 v115, v115
    v_cvt_pk_bf16_f32 v136, v112, v113
    v_cvt_pk_bf16_f32 v137, v114, v115
    v_cvt_pk_bf16_f32 v116, 0, v116
    v_cvt_pk_bf16_f32 v117, 0, v117
    v_cvt_pk_bf16_f32 v118, 0, v118
    v_cvt_pk_bf16_f32 v119, 0, v119
    v_add_f32 v116, v56, v116
    v_add_f32 v117, v56, v117
    v_add_f32 v118, v56, v118
    v_add_f32 v119, v56, v119
    v_cvt_pk_bf16_f32 v116, 0, v116
    v_cvt_pk_bf16_f32 v117, 0, v117
    v_cvt_pk_bf16_f32 v118, 0, v118
    v_cvt_pk_bf16_f32 v119, 0, v119
    v_mul_f32 v116, s40, v116
    v_mul_f32 v117, s40, v117
    v_mul_f32 v118, s40, v118
    v_mul_f32 v119, s40, v119
    v_exp_f32 v116, v116
    v_exp_f32 v117, v117
    v_exp_f32 v118, v118
    v_exp_f32 v119, v119
    v_cvt_pk_bf16_f32 v138, v116, v117
    v_cvt_pk_bf16_f32 v139, v118, v119
    v_cvt_pk_bf16_f32 v120, 0, v120
    v_cvt_pk_bf16_f32 v121, 0, v121
    v_cvt_pk_bf16_f32 v122, 0, v122
    v_cvt_pk_bf16_f32 v123, 0, v123
    v_add_f32 v120, v56, v120
    v_add_f32 v121, v56, v121
    v_add_f32 v122, v56, v122
    v_add_f32 v123, v56, v123
    v_cvt_pk_bf16_f32 v120, 0, v120
    v_cvt_pk_bf16_f32 v121, 0, v121
    v_cvt_pk_bf16_f32 v122, 0, v122
    v_cvt_pk_bf16_f32 v123, 0, v123
    v_mul_f32 v120, s40, v120
    v_mul_f32 v121, s40, v121
    v_mul_f32 v122, s40, v122
    v_mul_f32 v123, s40, v123
    v_exp_f32 v120, v120
    v_exp_f32 v121, v121
    v_exp_f32 v122, v122
    v_exp_f32 v123, v123
    v_cvt_pk_bf16_f32 v140, v120, v121
    v_cvt_pk_bf16_f32 v141, v122, v123
    v_cvt_pk_bf16_f32 v124, 0, v124
    v_cvt_pk_bf16_f32 v125, 0, v125
    v_cvt_pk_bf16_f32 v126, 0, v126
    v_cvt_pk_bf16_f32 v127, 0, v127
    v_add_f32 v124, v56, v124
    v_add_f32 v125, v56, v125
    v_add_f32 v126, v56, v126
    v_add_f32 v127, v56, v127
    v_cvt_pk_bf16_f32 v124, 0, v124
    v_cvt_pk_bf16_f32 v125, 0, v125
    v_cvt_pk_bf16_f32 v126, 0, v126
    v_cvt_pk_bf16_f32 v127, 0, v127
    v_mul_f32 v124, s40, v124
    v_mul_f32 v125, s40, v125
    v_mul_f32 v126, s40, v126
    v_mul_f32 v127, s40, v127
    v_exp_f32 v124, v124
    v_exp_f32 v125, v125
    v_exp_f32 v126, v126
    v_exp_f32 v127, v127
    v_cvt_pk_bf16_f32 v142, v124, v125
    v_cvt_pk_bf16_f32 v143, v126, v127
    v_mfma_f32_16x16x32_bf16 v[48:51], v[136:139], v[32:35], v[28:31]
    s_cmp_le_u32 s35, 8192
    v_mfma_f32_16x16x32_bf16 v[48:51], v[140:143], v[36:39], v[48:51]
    s_cbranch_scc1 L_loop
    v_cvt_pk_bf16_f32 v40, v44, v45
    v_cvt_pk_bf16_f32 v41, v46, v47
    s_nop 4
    v_cvt_pk_bf16_f32 v42, v48, v49
    v_cvt_pk_bf16_f32 v43, v50, v51
    s_mov_b64 exec, s[44:45]
    ds_write_b128 v14, v[40:43]
    s_mov_b64 exec, -1
    global_load_dword v160, v6, s[24:25] offset:1024
L_vl:
L_poll1:
    ds_read_b32 v4, v1
    s_sub_u32 s32, s32, 1
    s_cbranch_scc1 L_end
    s_waitcnt lgkmcnt(0)
    v_cmp_gt_u32 vcc, s57, v4
    s_cbranch_vccnz L_poll1
    ds_read_b128 v[128:131], v15 offset:256
    ds_read_b128 v[132:135], v15 offset:320
    ds_read_b128 v[136:139], v15 offset:384
    ds_read_b128 v[140:143], v15 offset:448
    ds_read_b64_tr_b16 v[96:97], v12 offset:0
    ds_read_b64_tr_b16 v[98:99], v12 offset:4096
    ds_read_b64_tr_b16 v[100:101], v13 offset:0
    ds_read_b64_tr_b16 v[102:103], v13 offset:4096
    ds_read_b64_tr_b16 v[104:105], v12 offset:8192
    ds_read_b64_tr_b16 v[106:107], v12 offset:12288
    ds_read_b64_tr_b16 v[108:109], v13 offset:8192
    ds_read_b64_tr_b16 v[110:111], v13 offset:12288
    ds_read_b64_tr_b16 v[112:113], v12 offset:16384
    ds_read_b64_tr_b16 v[114:115], v12 offset:20480
    ds_read_b64_tr_b16 v[116:117], v13 offset:16384
    ds_read_b64_tr_b16 v[118:119], v13 offset:20480
    v_mov_b32 v4, s57
    s_mov_b32 s56, s57
    v_add_u32 v15, 256, v15
    s_addk_i32 s57, 1024
    s_waitcnt lgkmcnt(12)
    ds_read_b64_tr_b16 v[120:121], v12 offset:24576
    ds_read_b64_tr_b16 v[122:123], v12 offset:28672
    ds_read_b64_tr_b16 v[124:125], v13 offset:24576
    ds_read_b64_tr_b16 v[126:127], v13 offset:28672
    v_mfma_f32_16x16x32_bf16 v[168:171], v[128:131], v[24:27], v[168:171]
    v_mfma_f32_16x16x32_bf16 v[168:171], v[132:135], v[24:27], v[168:171]
    v_mfma_f32_16x16x32_bf16 v[168:171], v[136:139], v[24:27], v[168:171]
    v_mfma_f32_16x16x32_bf16 v[168:171], v[140:143], v[24:27], v[168:171]
    v_xor_b32 v12, s34, v12
    v_xor_b32 v13, s34, v13
    s_xor_b32 s34, s34, 0x10000
    s_cmp_lt_u32 s57, s58
    s_waitcnt lgkmcnt(14)
    v_mfma_f32_16x16x32_bf16 v[152:155], v[128:131], v[96:99], v[152:155]
    s_waitcnt lgkmcnt(12)
    v_mfma_f32_16x16x32_bf16 v[156:159], v[128:131], v[100:103], v[156:159]
    s_waitcnt lgkmcnt(10)
    v_mfma_f32_16x16x32_bf16 v[152:155], v[132:135], v[104:107], v[152:155]
    s_waitcnt lgkmcnt(8)
    v_mfma_f32_16x16x32_bf16 v[156:159], v[132:135], v[108:111], v[156:159]
    s_waitcnt lgkmcnt(6)
    v_mfma_f32_16x16x32_bf16 v[152:155], v[136:139], v[112:115], v[152:155]
    s_waitcnt lgkmcnt(4)
    v_mfma_f32_16x16x32_bf16 v[156:159], v[136:139], v[116:119], v[156:159]
    s_waitcnt lgkmcnt(2)
    v_mfma_f32_16x16x32_bf16 v[152:155], v[140:143], v[120:123], v[152:155]
    s_waitcnt lgkmcnt(0)
    v_mfma_f32_16x16x32_bf16 v[156:159], v[140:143], v[124:127], v[156:159]
    ds_write_b32 v2, v4 offset:256
    s_cbranch_scc1 L_vl
    s_movk_i32 s58, 16384
    s_cmpk_le_u32 s35, 9216
    s_cbranch_scc1 L_loop
    ds_read_b128 v[128:131], v15 offset:256
    ds_read_b128 v[132:135], v15 offset:320
    ds_read_b128 v[136:139], v15 offset:384
    ds_read_b128 v[140:143], v15 offset:448
    v_mov_b32 v172, 0
    v_mov_b32 v173, v151
    v_mov_b32 v174, 0
    v_mov_b32 v175, 0
    s_mov_b32 s46, 0
    s_mov_b32 s47, s36
    s_waitcnt lgkmcnt(0)
    v_mfma_f32_16x16x32_bf16 v[168:171], v[128:131], v[24:27], v[168:171]
    v_mfma_f32_16x16x32_bf16 v[168:171], v[132:135], v[24:27], v[168:171]
    v_mfma_f32_16x16x32_bf16 v[168:171], v[136:139], v[24:27], v[168:171]
    v_mfma_f32_16x16x32_bf16 v[168:171], v[140:143], v[24:27], v[168:171]
    s_barrier
    ds_read_b32 v4, v1
    ds_read_b64_tr_b16 v[96:97], v12 offset:0
    ds_read_b64_tr_b16 v[98:99], v12 offset:4096
    ds_read_b64_tr_b16 v[100:101], v13 offset:0
    ds_read_b64_tr_b16 v[102:103], v13 offset:4096
    s_nop 1
    v_mov_b32 v150, v168
    v_add_f32 v144, 0x358637bd, v168
    s_waitcnt lgkmcnt(4)
    v_readfirstlane_b32 s31, v4
    s_nop 0
    s_andn2_b32 s29, 3, s31
    s_cselect_b32 s29, 0x400, 0
    s_cselect_b32 s58, -1, 12
    v_xor_b32 v186, s29, v186
    s_and_b32 s30, s31, 0xc0
    s_cmpk_eq_u32 s30, 0xc0
    s_waitcnt lgkmcnt(2)
    v_mfma_f32_16x16x32_bf16 v[152:155], v[128:131], v[96:99], v[152:155]
    s_waitcnt lgkmcnt(0)
    v_mfma_f32_16x16x32_bf16 v[156:159], v[128:131], v[100:103], v[156:159]
    s_barrier
    ds_read_b64_tr_b16 v[104:105], v12 offset:8192
    ds_read_b64_tr_b16 v[106:107], v12 offset:12288
    ds_read_b64_tr_b16 v[108:109], v13 offset:8192
    ds_read_b64_tr_b16 v[110:111], v13 offset:12288
    s_waitcnt lgkmcnt(2)
    v_mfma_f32_16x16x32_bf16 v[152:155], v[132:135], v[104:107], v[152:155]
    s_waitcnt lgkmcnt(0)
    v_mfma_f32_16x16x32_bf16 v[156:159], v[132:135], v[108:111], v[156:159]
    s_barrier
    ds_read_b64_tr_b16 v[112:113], v12 offset:16384
    ds_read_b64_tr_b16 v[114:115], v12 offset:20480
    ds_read_b64_tr_b16 v[116:117], v13 offset:16384
    ds_read_b64_tr_b16 v[118:119], v13 offset:20480
    s_waitcnt lgkmcnt(2)
    v_mfma_f32_16x16x32_bf16 v[152:155], v[136:139], v[112:115], v[152:155]
    s_waitcnt lgkmcnt(0)
    v_mfma_f32_16x16x32_bf16 v[156:159], v[136:139], v[116:119], v[156:159]
    s_cbranch_scc0 L_nb0
    s_mov_b32 exec_hi, 0xffff
    global_load_dwordx4 v[64:67], v186, s[24:25] sc1
    s_mov_b64 exec, -1
L_nb0:
    s_barrier
    ds_read_b64_tr_b16 v[120:121], v12 offset:24576
    ds_read_b64_tr_b16 v[122:123], v12 offset:28672
    ds_read_b64_tr_b16 v[124:125], v13 offset:24576
    ds_read_b64_tr_b16 v[126:127], v13 offset:28672
    s_cbranch_scc1 L_win
    s_waitcnt lgkmcnt(2)
    v_mfma_f32_16x16x32_bf16 v[152:155], v[140:143], v[120:123], v[152:155]
    s_waitcnt lgkmcnt(0)
    v_mfma_f32_16x16x32_bf16 v[156:159], v[140:143], v[124:127], v[156:159]
    s_mov_b64 exec, 0xffff
    s_nop 6
    v_mov_b32 v153, v156
    global_store_dwordx4 v6, v[150:153], s[24:25] offset:1024
    global_store_dwordx4 v6, v[150:153], s[24:25] sc1
    s_endpgm
L_retry:
    s_sub_u32 s58, s58, 1
    s_cselect_b32 s29, 0x400, 0
    v_xor_b32 v186, s29, v186
    s_mov_b64 exec, vcc
    s_sub_u32 s32, s32, 16
    s_cbranch_scc1 L_end
    global_load_dwordx4 v[64:67], v186, s[24:25] sc1
    s_waitcnt vmcnt(1)
    v_cmp_ne_u32 vcc, v151, v69
    v_mov_b32 v172, v68
    v_mov_b32 v174, v70
    v_mov_b32 v175, v71
    s_cbranch_vccz L_got
    s_mov_b64 exec, vcc
    s_branch L_chkb
L_win:
    s_waitcnt lgkmcnt(2)
    v_mfma_f32_16x16x32_bf16 v[152:155], v[140:143], v[120:123], v[152:155]
    s_waitcnt lgkmcnt(0)
    v_mfma_f32_16x16x32_bf16 v[156:159], v[140:143], v[124:127], v[156:159]
    s_mov_b32 exec_hi, 0xffff
L_chkb:
    global_load_dwordx4 v[68:71], v186, s[24:25] sc1
    s_waitcnt vmcnt(1)
    v_cmp_ne_u32 vcc, v151, v65
    v_mov_b32 v172, v64
    v_mov_b32 v174, v66
    v_mov_b32 v175, v67
    s_cbranch_vccnz L_retry
L_got:
    s_mov_b64 exec, -1
    s_nop 1
    v_add_f32_dpp v172, v172, v172 row_bcast:15 row_mask:0xa bank_mask:0xf
    v_permlane16_swap_b32 v174, v175
    s_nop 0
    v_add_f32_dpp v172, v172, v172 row_bcast:31 row_mask:0xc bank_mask:0xf
    v_add_f32 v174, v174, v175
    v_add_f32 v172, v172, v144
    v_cndmask_b32_e64 v152, v152, v156, s[46:47]
    v_add_f32 v175, v174, v152
    v_permlane32_swap_b32 v173, v174
    v_rcp_f32 v172, v172
    s_mov_b32 exec_lo, 0
    v_add_f32 v175, v175, v173
    v_mul_f32 v175, v175, v172
    v_cvt_pk_bf16_f32 v175, v175, v175
    global_store_short v22, v175, s[20:21]
L_end:
    s_endpgm
L_qpost:
    v_mov_b32 v146, 0x340637bd
    s_mov_b32 s29, 0x3c800000
    v_lshlrev_b32 v144, 16, v128
    v_and_b32 v145, s36, v128
    v_fma_f32 v144, v144, s29, v146
    v_fma_f32 v145, v145, s29, v146
    v_cvt_pk_bf16_f32 v32, v144, v145
    v_lshlrev_b32 v144, 16, v129
    v_and_b32 v145, s36, v129
    v_fma_f32 v144, v144, s29, v146
    v_fma_f32 v145, v145, s29, v146
    v_cvt_pk_bf16_f32 v33, v144, v145
    v_lshlrev_b32 v144, 16, v130
    v_and_b32 v145, s36, v130
    v_fma_f32 v144, v144, s29, v146
    v_fma_f32 v145, v145, s29, v146
    v_cvt_pk_bf16_f32 v34, v144, v145
    v_lshlrev_b32 v144, 16, v131
    v_and_b32 v145, s36, v131
    v_fma_f32 v144, v144, s29, v146
    v_fma_f32 v145, v145, s29, v146
    v_cvt_pk_bf16_f32 v35, v144, v145
    v_lshlrev_b32 v144, 16, v132
    v_and_b32 v145, s36, v132
    v_fma_f32 v144, v144, s29, v146
    v_fma_f32 v145, v145, s29, v146
    v_cvt_pk_bf16_f32 v36, v144, v145
    v_lshlrev_b32 v144, 16, v133
    v_and_b32 v145, s36, v133
    v_fma_f32 v144, v144, s29, v146
    v_fma_f32 v145, v145, s29, v146
    v_cvt_pk_bf16_f32 v37, v144, v145
    v_lshlrev_b32 v144, 16, v134
    v_and_b32 v145, s36, v134
    v_fma_f32 v144, v144, s29, v146
    v_fma_f32 v145, v145, s29, v146
    v_cvt_pk_bf16_f32 v38, v144, v145
    v_lshlrev_b32 v144, 16, v135
    v_and_b32 v145, s36, v135
    v_fma_f32 v144, v144, s29, v146
    v_fma_f32 v145, v145, s29, v146
    v_cvt_pk_bf16_f32 v39, v144, v145
    v_mfma_f32_16x16x32_bf16 v[28:31], v[24:27], v[32:35], 0
    s_add_u32 s42, s42, 0x9e3779b9
    v_mfma_f32_16x16x32_bf16 v[28:31], v[24:27], v[36:39], v[28:31]
    v_mov_b32 v151, s42
    s_cmp_eq_u32 s42, s63
    s_cselect_b32 s29, 4, s33
    s_cmp_lg_u32 s29, 0
    s_cbranch_scc1 L_c2
    s_mov_b64 exec, 1
    v_mov_b32 v180, 0
    v_mov_b32 v181, s42
    v_mov_b32 v182, s62
    v_mov_b32 v183, s63
    global_atomic_cmpswap_x2 v161, v[180:183], s[24:25] sc1
    s_mov_b64 exec, -1
L_c2:
    s_nop 1
    v_mul_f32 v28, 0x370637bd, v28
    v_mul_f32 v29, 0x370637bd, v29
    v_mul_f32 v30, 0x370637bd, v30
    v_mul_f32 v31, 0x370637bd, v31
    s_nop 1
    s_branch L_loop
L_codeend:
.section .rodata,"a"
.p2align 6
.amdhsa_kernel standalone__linear_kernel_rfa__decode_kernel
  .amdhsa_next_free_vgpr 256
  .amdhsa_next_free_sgpr 80
  .amdhsa_accum_offset 256
  .amdhsa_group_segment_fixed_size 0
  .amdhsa_kernarg_size 56
  .amdhsa_user_sgpr_count 2
  .amdhsa_user_sgpr_kernarg_segment_ptr 1
  .amdhsa_system_sgpr_workgroup_id_x 1
.end_amdhsa_kernel
```
